```python
import torch

def _softmax(x, axis=-1):
    return torch.softmax(x, dim=axis)
def _gelu(x):
    return torch.nn.functional.gelu(x, approximate="tanh")
def _silu(x):
    return torch.nn.functional.silu(x)
def _sigmoid(x):
    return torch.sigmoid(x)
def _layernorm(x, axis=-1, eps=1e-5):
    m = x.mean(dim=axis, keepdim=True)
    v = x.var(dim=axis, keepdim=True, unbiased=False)
    return (x - m) / torch.sqrt(v + eps)
def _scatter_add(tgt, idx, src, axis=0):
    return tgt.clone().index_add_(axis, idx, src)
def _segment_sum(src, seg, n):
    out = torch.zeros((n,) + src.shape[1:], dtype=src.dtype)
    return out.index_add_(0, seg, src)
def _pad(x, pw):
    flat = tuple(v for pair in reversed(pw) for v in pair)
    return torch.nn.functional.pad(x, flat)

kernel_name = 'standalone__mha_softmax__sampling'

def setup_inputs():

    _w = (lambda a: (lambda t: t.to(torch.bfloat16) if t.is_floating_point() else t)(torch.as_tensor(a)))
    B, H, Sq, Sk, D = 8, 32, 1, 8192, 128
    return {
        "q": _w((lambda *s: torch.randn(*s, dtype=torch.bfloat16) * 0.8)(B, H, Sq, D)),
        "k": _w((lambda *s: torch.randn(*s, dtype=torch.bfloat16) * 0.8)(B, H, Sk, D)),
        "v": _w((lambda *s: torch.randn(*s, dtype=torch.bfloat16) * 0.05)(B, H, Sk, D)),
    }

def reference(q, k, v):
    scale = q.shape[-1] ** -0.5
    scores = torch.einsum("bhqd,bhkd->bhqk", q, k) * scale
    p = _softmax(scores, axis=-1)
    return torch.einsum("bhqk,bhkd->bhqd", p, v)
```

```asm
; @launch grid=(256,1,1) block=(320,1,1) lds=2112
.amdgcn_target "amdgcn-amd-amdhsa--gfx950"
.text
.globl standalone__mha_softmax__sampling_kernel
.p2align 8
.type standalone__mha_softmax__sampling_kernel,@function
standalone__mha_softmax__sampling_kernel:
  s_cmp_ge_u32 s2, 256
  s_cbranch_scc1 L_end
  s_load_dwordx8 s[4:11], s[0:1], 0
  s_load_dwordx2 s[56:57], s[0:1], 32
  v_lshrrev_b32 v4, 6, v0
  v_and_b32 v0, 63, v0
  v_readfirstlane_b32 s28, v4
  v_bfe_u32 v5, v0, 2, 2
  v_lshrrev_b32 v6, 4, v0
  v_and_b32 v7, 3, v0
  s_getreg_b32 s34, hwreg(HW_REG_XCC_ID)
  s_and_b32 s34, s34, 1
  s_xor_b32 s34, s34, 1
  s_mul_i32 s34, s34, 2
  s_add_u32 s34, s34, 1
  s_cmp_eq_u32 s34, 1
  s_mov_b32 s39, 33824
  s_cselect_b32 s39, 32768, s39
  s_cmp_eq_u32 s28, 4
  s_cbranch_scc1 L_ctl
  s_mov_b32 s34, s39
  v_lshlrev_b32 v1, 8, v5
  v_lshl_add_u32 v1, v6, 6, v1
  v_lshl_add_u32 v1, v7, 4, v1
  v_lshlrev_b32 v2, 4, v0
  v_lshlrev_b32 v8, 4, v5
  v_lshl_add_u32 v8, v6, 6, v8
  v_mov_b32 v3, v1
  s_lshl_b32 s29, s2, 21
  s_lshl_b32 s36, s28, 12
  s_add_u32 s29, s29, s36
  s_mov_b32 s30, s29
  s_lshl_b32 s35, s2, 8
  s_mov_b32 s14, 0x20000000
  s_mov_b32 s15, 0x00020000
  s_mov_b32 s22, 0x10000
  s_mov_b32 s23, 0x00020000
  s_waitcnt lgkmcnt(0)
  s_mov_b32 s12, s6
  s_mov_b32 s13, s7
  s_mov_b32 s20, s4
  s_mov_b32 s21, s5
  buffer_load_dwordx4 v[48:51], v8, s[20:23], s35 offen nt
  buffer_load_dwordx4 v[92:95], v3, s[12:15], s30 offen nt
  buffer_load_dwordx4 v[96:99], v3, s[12:15], s30 offen offset:1024 nt
  buffer_load_dwordx4 v[100:103], v3, s[12:15], s30 offen offset:2048 nt
  buffer_load_dwordx4 v[104:107], v3, s[12:15], s30 offen offset:3072 nt
  s_add_u32 s30, s30, 16384
  buffer_load_dwordx4 v[108:111], v3, s[12:15], s30 offen nt
  buffer_load_dwordx4 v[112:115], v3, s[12:15], s30 offen offset:1024 nt
  buffer_load_dwordx4 v[116:119], v3, s[12:15], s30 offen offset:2048 nt
  buffer_load_dwordx4 v[120:123], v3, s[12:15], s30 offen offset:3072 nt
  s_add_u32 s30, s30, 16384
  buffer_load_dwordx4 v[124:127], v3, s[12:15], s30 offen nt
  buffer_load_dwordx4 v[128:131], v3, s[12:15], s30 offen offset:1024 nt
  buffer_load_dwordx4 v[132:135], v3, s[12:15], s30 offen offset:2048 nt
  buffer_load_dwordx4 v[136:139], v3, s[12:15], s30 offen offset:3072 nt
  s_add_u32 s30, s30, 16384
  buffer_load_dwordx4 v[140:143], v3, s[12:15], s30 offen nt
  buffer_load_dwordx4 v[144:147], v3, s[12:15], s30 offen offset:1024 nt
  buffer_load_dwordx4 v[148:151], v3, s[12:15], s30 offen offset:2048 nt
  buffer_load_dwordx4 v[152:155], v3, s[12:15], s30 offen offset:3072 nt
  s_add_u32 s30, s30, 16384
  s_mov_b32 s32, 0x3e0293ee
  s_mov_b32 s24, s10
  s_mov_b32 s25, s11
  s_mov_b32 s26, 0x10000
  s_mov_b32 s27, 0x00020000
  v_and_b32 v9, 15, v0
  v_mov_b32 v10, 0x0100
  v_mov_b32 v11, 0x0302
  v_cmp_lt_u32 vcc, 7, v9
  s_nop 1
  v_cndmask_b32 v10, v10, v11, vcc
  v_or_b32 v11, 0x0c0c0000, v10
  v_lshlrev_b32 v12, 16, v10
  v_or_b32 v12, 0x0c0c, v12
  v_and_b32 v10, 1, v9
  v_cmp_eq_u32 vcc, 1, v10
  s_nop 1
  v_cndmask_b32 v11, v11, v12, vcc
  v_bfe_u32 v10, v9, 1, 2
  v_mov_b32 v12, 0x0c0c0c0c
  v_cmp_eq_u32 vcc, 0, v10
  s_nop 1
  v_cndmask_b32 v40, v12, v11, vcc
  v_cmp_eq_u32 vcc, 1, v10
  s_nop 1
  v_cndmask_b32 v41, v12, v11, vcc
  v_cmp_eq_u32 vcc, 2, v10
  s_nop 1
  v_cndmask_b32 v42, v12, v11, vcc
  v_cmp_eq_u32 vcc, 3, v10
  s_nop 1
  v_cndmask_b32 v43, v12, v11, vcc
  v_mov_b32 v44, 0
  v_mov_b32 v45, 0
  v_mov_b32 v46, 0
  v_mov_b32 v47, 0
  v_mov_b32 v53, 0xff800000
  v_mov_b32 v88, 0xff800000
  v_lshlrev_b32 v54, 7, v6
  v_and_b32 v10, 7, v0
  v_lshl_add_u32 v54, v10, 2, v54
  s_lshl_b32 s36, s28, 9
  v_add_u32 v54, s36, v54
  s_lshl_b32 s36, s28, 3
  v_mov_b32 v55, s36
  s_lshl_b32 s36, s28, 2
  v_mov_b32 v13, s36
  v_mov_b32 v14, 0
  s_mov_b32 s31, 1
  s_waitcnt vmcnt(16)
  v_cmp_eq_u32 vcc, 0, v7
  s_nop 1
  v_cndmask_b32 v16, 0, v48, vcc
  v_cndmask_b32 v17, 0, v49, vcc
  v_cndmask_b32 v18, 0, v50, vcc
  v_cndmask_b32 v19, 0, v51, vcc
  v_cmp_eq_u32 vcc, 1, v7
  s_nop 1
  v_cndmask_b32 v20, 0, v48, vcc
  v_cndmask_b32 v21, 0, v49, vcc
  v_cndmask_b32 v22, 0, v50, vcc
  v_cndmask_b32 v23, 0, v51, vcc
  v_cmp_eq_u32 vcc, 2, v7
  s_nop 1
  v_cndmask_b32 v24, 0, v48, vcc
  v_cndmask_b32 v25, 0, v49, vcc
  v_cndmask_b32 v26, 0, v50, vcc
  v_cndmask_b32 v27, 0, v51, vcc
  v_cmp_eq_u32 vcc, 3, v7
  s_nop 1
  v_cndmask_b32 v28, 0, v48, vcc
  v_cndmask_b32 v29, 0, v49, vcc
  v_cndmask_b32 v30, 0, v50, vcc
  v_cndmask_b32 v31, 0, v51, vcc
  s_barrier
L_khead:
  s_cmp_lt_u32 s31, 32
  s_cbranch_scc1 L_kgo
  s_mov_b32 s12, s8
  s_mov_b32 s13, s9
  v_mov_b32 v3, v2
  s_mov_b32 s30, s29
L_kgo:
  v_mov_b32 v56, v57
  v_mov_b32 v57, v58
  v_mov_b32 v58, v59
  v_mov_b32 v59, v60
  v_mov_b32 v60, v61
  v_mov_b32 v61, v62
  v_mov_b32 v62, v63
  v_mov_b32 v63, v64
  v_mov_b32 v64, v65
  v_mov_b32 v65, v66
  v_mov_b32 v66, v67
  v_mov_b32 v67, v68
  v_mov_b32 v68, v69
  v_mov_b32 v69, v70
  v_mov_b32 v70, v71
  v_mov_b32 v71, v72
  v_mov_b32 v72, v73
  v_mov_b32 v73, v74
  v_mov_b32 v74, v75
  v_mov_b32 v75, v76
  v_mov_b32 v76, v77
  v_mov_b32 v77, v78
  v_mov_b32 v78, v79
  v_mov_b32 v79, v80
  v_mov_b32 v80, v81
  v_mov_b32 v81, v82
  v_mov_b32 v82, v83
  v_mov_b32 v83, v84
  v_mov_b32 v84, v85
  v_mov_b32 v85, v86
  v_mov_b32 v86, v87
L_k0:
  s_bitcmp1_b32 s34, 0
  s_cbranch_scc1 L_w179
  s_waitcnt vmcnt(4)
L_w179:
  s_waitcnt vmcnt(5)
  v_mfma_f32_16x16x32_bf16 v[32:35], v[92:95], v[16:19], 0
  buffer_load_dwordx4 v[92:95], v3, s[12:15], s30 offen nt
  s_bitcmp1_b32 s34, 1
  s_cbranch_scc1 L_w186
  s_waitcnt vmcnt(4)
L_w186:
  s_waitcnt vmcnt(5)
  v_mfma_f32_16x16x32_bf16 v[32:35], v[96:99], v[20:23], v[32:35]
  buffer_load_dwordx4 v[96:99], v3, s[12:15], s30 offen offset:1024 nt
  v_add_u32 v14, 1, v14
  ds_write_b32 v13, v14 offset:2080
  s_bitcmp1_b32 s34, 2
  s_cbranch_scc1 L_w195
  s_waitcnt vmcnt(4)
L_w195:
  s_waitcnt vmcnt(5)
  v_mfma_f32_16x16x32_bf16 v[32:35], v[100:103], v[24:27], v[32:35]
  buffer_load_dwordx4 v[100:103], v3, s[12:15], s30 offen offset:2048 nt
  s_bitcmp1_b32 s34, 3
  s_cbranch_scc1 L_w202
  s_waitcnt vmcnt(4)
L_w202:
  s_waitcnt vmcnt(5)
  v_mfma_f32_16x16x32_bf16 v[32:35], v[104:107], v[28:31], v[32:35]
  buffer_load_dwordx4 v[104:107], v3, s[12:15], s30 offen offset:3072 nt
  s_add_u32 s30, s30, 16384
  s_bitcmp1_b32 s34, 4
  s_cbranch_scc1 L_w210
  s_waitcnt vmcnt(4)
L_w210:
  s_waitcnt vmcnt(5)
  v_mfma_f32_16x16x32_bf16 v[36:39], v[108:111], v[16:19], 0
  buffer_load_dwordx4 v[108:111], v3, s[12:15], s30 offen nt
  s_bitcmp1_b32 s34, 5
  s_cbranch_scc1 L_w217
  s_waitcnt vmcnt(4)
L_w217:
  s_waitcnt vmcnt(5)
  v_mfma_f32_16x16x32_bf16 v[36:39], v[112:115], v[20:23], v[36:39]
  buffer_load_dwordx4 v[112:115], v3, s[12:15], s30 offen offset:1024 nt
  v_add_f32_dpp v87, v33, v32 row_ror:12 row_mask:0xf bank_mask:0x1
  v_add_u32 v14, 1, v14
  ds_write_b32 v13, v14 offset:2080
  s_bitcmp1_b32 s34, 6
  s_cbranch_scc1 L_w227
  s_waitcnt vmcnt(4)
L_w227:
  s_waitcnt vmcnt(5)
  v_mfma_f32_16x16x32_bf16 v[36:39], v[116:119], v[24:27], v[36:39]
  buffer_load_dwordx4 v[116:119], v3, s[12:15], s30 offen offset:2048 nt
  v_add_f32_dpp v87, v34, v87 row_ror:8 row_mask:0xf bank_mask:0x1
  s_bitcmp1_b32 s34, 7
  s_cbranch_scc1 L_w235
  s_waitcnt vmcnt(4)
L_w235:
  s_waitcnt vmcnt(5)
  v_mfma_f32_16x16x32_bf16 v[36:39], v[120:123], v[28:31], v[36:39]
  buffer_load_dwordx4 v[120:123], v3, s[12:15], s30 offen offset:3072 nt
  s_add_u32 s30, s30, 16384
  v_add_f32_dpp v87, v35, v87 row_ror:4 row_mask:0xf bank_mask:0x1
  s_bitcmp1_b32 s34, 8
  s_cbranch_scc1 L_w244
  s_waitcnt vmcnt(4)
L_w244:
  s_waitcnt vmcnt(5)
  v_mfma_f32_16x16x32_bf16 v[32:35], v[124:127], v[16:19], 0
  buffer_load_dwordx4 v[124:127], v3, s[12:15], s30 offen nt
  s_bitcmp1_b32 s34, 9
  s_cbranch_scc1 L_w251
  s_waitcnt vmcnt(4)
L_w251:
  s_waitcnt vmcnt(5)
  v_mfma_f32_16x16x32_bf16 v[32:35], v[128:131], v[20:23], v[32:35]
  buffer_load_dwordx4 v[128:131], v3, s[12:15], s30 offen offset:1024 nt
  v_add_f32_dpp v87, v38, v37 row_ror:12 row_mask:0xf bank_mask:0x2
  v_add_u32 v14, 1, v14
  ds_write_b32 v13, v14 offset:2080
  s_bitcmp1_b32 s34, 10
  s_cbranch_scc1 L_w261
  s_waitcnt vmcnt(4)
L_w261:
  s_waitcnt vmcnt(5)
  v_mfma_f32_16x16x32_bf16 v[32:35], v[132:135], v[24:27], v[32:35]
  buffer_load_dwordx4 v[132:135], v3, s[12:15], s30 offen offset:2048 nt
  v_add_f32_dpp v87, v39, v87 row_ror:8 row_mask:0xf bank_mask:0x2
  s_bitcmp1_b32 s34, 11
  s_cbranch_scc1 L_w269
  s_waitcnt vmcnt(4)
L_w269:
  s_waitcnt vmcnt(5)
  v_mfma_f32_16x16x32_bf16 v[32:35], v[136:139], v[28:31], v[32:35]
  buffer_load_dwordx4 v[136:139], v3, s[12:15], s30 offen offset:3072 nt
  s_add_u32 s30, s30, 16384
  v_add_f32_dpp v87, v36, v87 row_ror:4 row_mask:0xf bank_mask:0x2
  s_bitcmp1_b32 s34, 12
  s_cbranch_scc1 L_w278
  s_waitcnt vmcnt(4)
L_w278:
  s_waitcnt vmcnt(5)
  v_mfma_f32_16x16x32_bf16 v[36:39], v[140:143], v[16:19], 0
  buffer_load_dwordx4 v[140:143], v3, s[12:15], s30 offen nt
  ds_read_b32 v15, v13 offset:2096
  s_bitcmp1_b32 s34, 13
  s_cbranch_scc1 L_w286
  s_waitcnt vmcnt(4)
L_w286:
  s_waitcnt vmcnt(5)
  v_mfma_f32_16x16x32_bf16 v[36:39], v[144:147], v[20:23], v[36:39]
  buffer_load_dwordx4 v[144:147], v3, s[12:15], s30 offen offset:1024 nt
  v_add_f32_dpp v87, v35, v34 row_ror:12 row_mask:0xf bank_mask:0x4
  v_add_u32 v14, 1, v14
  ds_write_b32 v13, v14 offset:2080
  s_bitcmp1_b32 s34, 14
  s_cbranch_scc1 L_w296
  s_waitcnt vmcnt(4)
L_w296:
  s_waitcnt vmcnt(5)
  v_mfma_f32_16x16x32_bf16 v[36:39], v[148:151], v[24:27], v[36:39]
  buffer_load_dwordx4 v[148:151], v3, s[12:15], s30 offen offset:2048 nt
  v_add_f32_dpp v87, v32, v87 row_ror:8 row_mask:0xf bank_mask:0x4
  s_bitcmp1_b32 s34, 15
  s_cbranch_scc1 L_w304
  s_waitcnt vmcnt(4)
L_w304:
  s_waitcnt vmcnt(5)
  v_mfma_f32_16x16x32_bf16 v[36:39], v[152:155], v[28:31], v[36:39]
  buffer_load_dwordx4 v[152:155], v3, s[12:15], s30 offen offset:3072 nt
  s_add_u32 s30, s30, 16384
  v_add_f32_dpp v87, v33, v87 row_ror:4 row_mask:0xf bank_mask:0x4
  s_waitcnt lgkmcnt(0)
  v_readfirstlane_b32 s34, v15
  s_add_u32 s31, s31, 1
  s_cmp_gt_u32 s31, 32
  s_nop 0
  v_add_f32_dpp v87, v36, v39 row_ror:12 row_mask:0xf bank_mask:0x8
  s_nop 1
  v_add_f32_dpp v87, v37, v87 row_ror:8 row_mask:0xf bank_mask:0x8
  s_nop 1
  v_add_f32_dpp v87, v38, v87 row_ror:4 row_mask:0xf bank_mask:0x8
  v_max_f32 v53, v53, v87
  s_cbranch_scc0 L_khead
L_soft:
  s_nop 0
  v_max_f32_dpp v53, v53, v53 row_ror:1 row_mask:0xf bank_mask:0xf
  s_nop 1
  v_max_f32_dpp v53, v53, v53 row_ror:2 row_mask:0xf bank_mask:0xf
  s_nop 1
  v_max_f32_dpp v53, v53, v53 row_ror:4 row_mask:0xf bank_mask:0xf
  s_nop 1
  v_max_f32_dpp v53, v53, v53 row_ror:8 row_mask:0xf bank_mask:0xf
  s_nop 1
  v_max_f32_dpp v53, v53, v53 row_bcast:15 row_mask:0xa bank_mask:0xf
  s_nop 1
  v_max_f32_dpp v53, v53, v53 row_bcast:31 row_mask:0xc bank_mask:0xf
  s_nop 0
  v_readlane_b32 s33, v53, 63
  s_nop 1
  v_subrev_f32 v56, s33, v56
  v_mul_f32 v56, s32, v56
  v_exp_f32 v56, v56
  s_nop 0
  v_and_b32 v4, 0xffff0000, v56
  v_mov_b32 v52, v56
  v_sub_f32 v5, v56, v4
  v_cvt_pk_bf16_f32 v56, v4, v5
  s_nop 1
  v_mov_b32_dpp v48, v56 row_newbcast:0 row_mask:0xf bank_mask:0xf
  v_perm_b32 v16, v48, v48, v40
  v_perm_b32 v17, v48, v48, v41
  v_perm_b32 v18, v48, v48, v42
  v_perm_b32 v19, v48, v48, v43
  v_mov_b32_dpp v49, v56 row_newbcast:1 row_mask:0xf bank_mask:0xf
  v_perm_b32 v20, v49, v49, v40
  v_perm_b32 v21, v49, v49, v41
  v_perm_b32 v22, v49, v49, v42
  v_perm_b32 v23, v49, v49, v43
  s_mov_b32 s31, 1
L_vhead:
L_v0:
  s_bitcmp1_b32 s34, 0
  s_cbranch_scc1 L_w350
  s_waitcnt vmcnt(4)
L_w350:
  s_waitcnt vmcnt(5)
  v_mfma_f32_16x16x32_bf16 v[44:47], v[92:95], v[16:19], v[44:47]
  buffer_load_dwordx4 v[92:95], v3, s[12:15], s30 offen nt
  v_mov_b32_dpp v50, v56 row_newbcast:2 row_mask:0xf bank_mask:0xf
  v_perm_b32 v24, v50, v50, v40
  v_perm_b32 v25, v50, v50, v41
  v_perm_b32 v26, v50, v50, v42
  v_perm_b32 v27, v50, v50, v43
  s_bitcmp1_b32 s34, 1
  s_cbranch_scc1 L_w362
  s_waitcnt vmcnt(4)
L_w362:
  s_waitcnt vmcnt(5)
  v_mfma_f32_16x16x32_bf16 v[44:47], v[96:99], v[20:23], v[44:47]
  buffer_load_dwordx4 v[96:99], v3, s[12:15], s30 offen offset:1024 nt
  v_mov_b32_dpp v51, v56 row_newbcast:3 row_mask:0xf bank_mask:0xf
  v_perm_b32 v28, v51, v51, v40
  v_perm_b32 v29, v51, v51, v41
  v_perm_b32 v30, v51, v51, v42
  v_perm_b32 v31, v51, v51, v43
  v_add_u32 v14, 1, v14
  ds_write_b32 v13, v14 offset:2080
  s_bitcmp1_b32 s34, 2
  s_cbranch_scc1 L_w376
  s_waitcnt vmcnt(4)
L_w376:
  s_waitcnt vmcnt(5)
  v_mfma_f32_16x16x32_bf16 v[44:47], v[100:103], v[24:27], v[44:47]
  buffer_load_dwordx4 v[100:103], v3, s[12:15], s30 offen offset:2048 nt
  v_subrev_f32 v57, s33, v57
  v_mul_f32 v57, s32, v57
  v_exp_f32 v57, v57
  s_nop 0
  v_and_b32 v4, 0xffff0000, v57
  v_add_f32 v52, v52, v57
  v_sub_f32 v5, v57, v4
  v_cvt_pk_bf16_f32 v57, v4, v5
  v_mov_b32_dpp v48, v56 row_newbcast:4 row_mask:0xf bank_mask:0xf
  v_perm_b32 v16, v48, v48, v40
  v_perm_b32 v17, v48, v48, v41
  v_perm_b32 v18, v48, v48, v42
  v_perm_b32 v19, v48, v48, v43
  s_bitcmp1_b32 s34, 3
  s_cbranch_scc1 L_w395
  s_waitcnt vmcnt(4)
L_w395:
  s_waitcnt vmcnt(5)
  v_mfma_f32_16x16x32_bf16 v[44:47], v[104:107], v[28:31], v[44:47]
  buffer_load_dwordx4 v[104:107], v3, s[12:15], s30 offen offset:3072 nt
  s_add_u32 s30, s30, 16384
  v_mov_b32_dpp v49, v56 row_newbcast:5 row_mask:0xf bank_mask:0xf
  v_perm_b32 v20, v49, v49, v40
  v_perm_b32 v21, v49, v49, v41
  v_perm_b32 v22, v49, v49, v42
  v_perm_b32 v23, v49, v49, v43
  s_bitcmp1_b32 s34, 4
  s_cbranch_scc1 L_w408
  s_waitcnt vmcnt(4)
L_w408:
  s_waitcnt vmcnt(5)
  v_mfma_f32_16x16x32_bf16 v[44:47], v[108:111], v[16:19], v[44:47]
  buffer_load_dwordx4 v[108:111], v3, s[12:15], s30 offen nt
  v_mov_b32_dpp v50, v56 row_newbcast:6 row_mask:0xf bank_mask:0xf
  v_perm_b32 v24, v50, v50, v40
  v_perm_b32 v25, v50, v50, v41
  v_perm_b32 v26, v50, v50, v42
  v_perm_b32 v27, v50, v50, v43
  s_bitcmp1_b32 s34, 5
  s_cbranch_scc1 L_w420
  s_waitcnt vmcnt(4)
L_w420:
  s_waitcnt vmcnt(5)
  v_mfma_f32_16x16x32_bf16 v[44:47], v[112:115], v[20:23], v[44:47]
  buffer_load_dwordx4 v[112:115], v3, s[12:15], s30 offen offset:1024 nt
  v_mov_b32_dpp v51, v56 row_newbcast:7 row_mask:0xf bank_mask:0xf
  v_perm_b32 v28, v51, v51, v40
  v_perm_b32 v29, v51, v51, v41
  v_perm_b32 v30, v51, v51, v42
  v_perm_b32 v31, v51, v51, v43
  v_add_u32 v14, 1, v14
  ds_write_b32 v13, v14 offset:2080
  s_bitcmp1_b32 s34, 6
  s_cbranch_scc1 L_w434
  s_waitcnt vmcnt(4)
L_w434:
  s_waitcnt vmcnt(5)
  v_mfma_f32_16x16x32_bf16 v[44:47], v[116:119], v[24:27], v[44:47]
  buffer_load_dwordx4 v[116:119], v3, s[12:15], s30 offen offset:2048 nt
  v_mov_b32_dpp v48, v56 row_newbcast:8 row_mask:0xf bank_mask:0xf
  v_perm_b32 v16, v48, v48, v40
  v_perm_b32 v17, v48, v48, v41
  v_perm_b32 v18, v48, v48, v42
  v_perm_b32 v19, v48, v48, v43
  s_bitcmp1_b32 s34, 7
  s_cbranch_scc1 L_w446
  s_waitcnt vmcnt(4)
L_w446:
  s_waitcnt vmcnt(5)
  v_mfma_f32_16x16x32_bf16 v[44:47], v[120:123], v[28:31], v[44:47]
  buffer_load_dwordx4 v[120:123], v3, s[12:15], s30 offen offset:3072 nt
  s_add_u32 s30, s30, 16384
  v_mov_b32_dpp v49, v56 row_newbcast:9 row_mask:0xf bank_mask:0xf
  v_perm_b32 v20, v49, v49, v40
  v_perm_b32 v21, v49, v49, v41
  v_perm_b32 v22, v49, v49, v42
  v_perm_b32 v23, v49, v49, v43
  s_bitcmp1_b32 s34, 8
  s_cbranch_scc1 L_w459
  s_waitcnt vmcnt(4)
L_w459:
  s_waitcnt vmcnt(5)
  v_mfma_f32_16x16x32_bf16 v[44:47], v[124:127], v[16:19], v[44:47]
  buffer_load_dwordx4 v[124:127], v3, s[12:15], s30 offen nt
  v_mov_b32_dpp v50, v56 row_newbcast:10 row_mask:0xf bank_mask:0xf
  v_perm_b32 v24, v50, v50, v40
  v_perm_b32 v25, v50, v50, v41
  v_perm_b32 v26, v50, v50, v42
  v_perm_b32 v27, v50, v50, v43
  s_bitcmp1_b32 s34, 9
  s_cbranch_scc1 L_w471
  s_waitcnt vmcnt(4)
L_w471:
  s_waitcnt vmcnt(5)
  v_mfma_f32_16x16x32_bf16 v[44:47], v[128:131], v[20:23], v[44:47]
  buffer_load_dwordx4 v[128:131], v3, s[12:15], s30 offen offset:1024 nt
  v_mov_b32_dpp v51, v56 row_newbcast:11 row_mask:0xf bank_mask:0xf
  v_perm_b32 v28, v51, v51, v40
  v_perm_b32 v29, v51, v51, v41
  v_perm_b32 v30, v51, v51, v42
  v_perm_b32 v31, v51, v51, v43
  v_add_u32 v14, 1, v14
  ds_write_b32 v13, v14 offset:2080
  s_bitcmp1_b32 s34, 10
  s_cbranch_scc1 L_w485
  s_waitcnt vmcnt(4)
L_w485:
  s_waitcnt vmcnt(5)
  v_mfma_f32_16x16x32_bf16 v[44:47], v[132:135], v[24:27], v[44:47]
  buffer_load_dwordx4 v[132:135], v3, s[12:15], s30 offen offset:2048 nt
  v_mov_b32_dpp v48, v56 row_newbcast:12 row_mask:0xf bank_mask:0xf
  v_perm_b32 v16, v48, v48, v40
  v_perm_b32 v17, v48, v48, v41
  v_perm_b32 v18, v48, v48, v42
  v_perm_b32 v19, v48, v48, v43
  s_bitcmp1_b32 s34, 11
  s_cbranch_scc1 L_w497
  s_waitcnt vmcnt(4)
L_w497:
  s_waitcnt vmcnt(5)
  v_mfma_f32_16x16x32_bf16 v[44:47], v[136:139], v[28:31], v[44:47]
  buffer_load_dwordx4 v[136:139], v3, s[12:15], s30 offen offset:3072 nt
  s_add_u32 s30, s30, 16384
  v_mov_b32_dpp v49, v56 row_newbcast:13 row_mask:0xf bank_mask:0xf
  v_perm_b32 v20, v49, v49, v40
  v_perm_b32 v21, v49, v49, v41
  v_perm_b32 v22, v49, v49, v42
  v_perm_b32 v23, v49, v49, v43
  s_bitcmp1_b32 s34, 12
  s_cbranch_scc1 L_w510
  s_waitcnt vmcnt(4)
L_w510:
  s_waitcnt vmcnt(5)
  v_mfma_f32_16x16x32_bf16 v[44:47], v[140:143], v[16:19], v[44:47]
  buffer_load_dwordx4 v[140:143], v3, s[12:15], s30 offen nt
  v_mov_b32_dpp v50, v56 row_newbcast:14 row_mask:0xf bank_mask:0xf
  v_perm_b32 v24, v50, v50, v40
  v_perm_b32 v25, v50, v50, v41
  v_perm_b32 v26, v50, v50, v42
  v_perm_b32 v27, v50, v50, v43
  ds_read_b32 v15, v13 offset:2096
  s_bitcmp1_b32 s34, 13
  s_cbranch_scc1 L_w523
  s_waitcnt vmcnt(4)
L_w523:
  s_waitcnt vmcnt(5)
  v_mfma_f32_16x16x32_bf16 v[44:47], v[144:147], v[20:23], v[44:47]
  buffer_load_dwordx4 v[144:147], v3, s[12:15], s30 offen offset:1024 nt
  v_mov_b32_dpp v51, v56 row_newbcast:15 row_mask:0xf bank_mask:0xf
  v_perm_b32 v28, v51, v51, v40
  v_perm_b32 v29, v51, v51, v41
  v_perm_b32 v30, v51, v51, v42
  v_perm_b32 v31, v51, v51, v43
  v_add_u32 v14, 1, v14
  ds_write_b32 v13, v14 offset:2080
  s_bitcmp1_b32 s34, 14
  s_cbranch_scc1 L_w537
  s_waitcnt vmcnt(4)
L_w537:
  s_waitcnt vmcnt(5)
  v_mfma_f32_16x16x32_bf16 v[44:47], v[148:151], v[24:27], v[44:47]
  buffer_load_dwordx4 v[148:151], v3, s[12:15], s30 offen offset:2048 nt
  v_mov_b32_dpp v48, v57 row_newbcast:0 row_mask:0xf bank_mask:0xf
  v_perm_b32 v16, v48, v48, v40
  v_perm_b32 v17, v48, v48, v41
  v_perm_b32 v18, v48, v48, v42
  v_perm_b32 v19, v48, v48, v43
  s_bitcmp1_b32 s34, 15
  s_cbranch_scc1 L_w549
  s_waitcnt vmcnt(4)
L_w549:
  s_waitcnt vmcnt(5)
  v_mfma_f32_16x16x32_bf16 v[44:47], v[152:155], v[28:31], v[44:47]
  buffer_load_dwordx4 v[152:155], v3, s[12:15], s30 offen offset:3072 nt
  s_add_u32 s30, s30, 16384
  v_mov_b32_dpp v49, v57 row_newbcast:1 row_mask:0xf bank_mask:0xf
  v_perm_b32 v20, v49, v49, v40
  v_perm_b32 v21, v49, v49, v41
  v_perm_b32 v22, v49, v49, v42
  v_perm_b32 v23, v49, v49, v43
  v_mov_b32 v56, v57
  v_mov_b32 v57, v58
  v_mov_b32 v58, v59
  v_mov_b32 v59, v60
  v_mov_b32 v60, v61
  v_mov_b32 v61, v62
  v_mov_b32 v62, v63
  v_mov_b32 v63, v64
  v_mov_b32 v64, v65
  v_mov_b32 v65, v66
  v_mov_b32 v66, v67
  v_mov_b32 v67, v68
  v_mov_b32 v68, v69
  v_mov_b32 v69, v70
  v_mov_b32 v70, v71
  v_mov_b32 v71, v72
  v_mov_b32 v72, v73
  v_mov_b32 v73, v74
  v_mov_b32 v74, v75
  v_mov_b32 v75, v76
  v_mov_b32 v76, v77
  v_mov_b32 v77, v78
  v_mov_b32 v78, v79
  v_mov_b32 v79, v80
  v_mov_b32 v80, v81
  v_mov_b32 v81, v82
  v_mov_b32 v82, v83
  v_mov_b32 v83, v84
  v_mov_b32 v84, v85
  v_mov_b32 v85, v86
  v_mov_b32 v86, v87
  v_mov_b32 v87, v88
  s_waitcnt lgkmcnt(0)
  v_readfirstlane_b32 s34, v15
  s_add_u32 s31, s31, 1
  s_cmp_lt_u32 s31, 32
  s_cbranch_scc1 L_vhead
L_last:
  s_waitcnt vmcnt(15)
  v_mfma_f32_16x16x32_bf16 v[44:47], v[92:95], v[16:19], v[44:47]
  v_mov_b32_dpp v50, v56 row_newbcast:2 row_mask:0xf bank_mask:0xf
  v_perm_b32 v24, v50, v50, v40
  v_perm_b32 v25, v50, v50, v41
  v_perm_b32 v26, v50, v50, v42
  v_perm_b32 v27, v50, v50, v43
  v_add_f32_dpp v52, v52, v52 row_ror:1 row_mask:0xf bank_mask:0xf
  s_waitcnt vmcnt(14)
  v_mfma_f32_16x16x32_bf16 v[44:47], v[96:99], v[20:23], v[44:47]
  v_mov_b32_dpp v51, v56 row_newbcast:3 row_mask:0xf bank_mask:0xf
  v_perm_b32 v28, v51, v51, v40
  v_perm_b32 v29, v51, v51, v41
  v_perm_b32 v30, v51, v51, v42
  v_perm_b32 v31, v51, v51, v43
  v_add_f32_dpp v52, v52, v52 row_ror:2 row_mask:0xf bank_mask:0xf
  s_waitcnt vmcnt(13)
  v_mfma_f32_16x16x32_bf16 v[44:47], v[100:103], v[24:27], v[44:47]
  v_mov_b32_dpp v48, v56 row_newbcast:4 row_mask:0xf bank_mask:0xf
  v_perm_b32 v16, v48, v48, v40
  v_perm_b32 v17, v48, v48, v41
  v_perm_b32 v18, v48, v48, v42
  v_perm_b32 v19, v48, v48, v43
  v_add_f32_dpp v52, v52, v52 row_ror:4 row_mask:0xf bank_mask:0xf
  s_waitcnt vmcnt(12)
  v_mfma_f32_16x16x32_bf16 v[44:47], v[104:107], v[28:31], v[44:47]
  v_mov_b32_dpp v49, v56 row_newbcast:5 row_mask:0xf bank_mask:0xf
  v_perm_b32 v20, v49, v49, v40
  v_perm_b32 v21, v49, v49, v41
  v_perm_b32 v22, v49, v49, v42
  v_perm_b32 v23, v49, v49, v43
  v_add_f32_dpp v52, v52, v52 row_ror:8 row_mask:0xf bank_mask:0xf
  s_waitcnt vmcnt(11)
  v_mfma_f32_16x16x32_bf16 v[44:47], v[108:111], v[16:19], v[44:47]
  v_mov_b32_dpp v50, v56 row_newbcast:6 row_mask:0xf bank_mask:0xf
  v_perm_b32 v24, v50, v50, v40
  v_perm_b32 v25, v50, v50, v41
  v_perm_b32 v26, v50, v50, v42
  v_perm_b32 v27, v50, v50, v43
  v_add_f32_dpp v52, v52, v52 row_bcast:15 row_mask:0xa bank_mask:0xf
  s_waitcnt vmcnt(10)
  v_mfma_f32_16x16x32_bf16 v[44:47], v[112:115], v[20:23], v[44:47]
  v_mov_b32_dpp v51, v56 row_newbcast:7 row_mask:0xf bank_mask:0xf
  v_perm_b32 v28, v51, v51, v40
  v_perm_b32 v29, v51, v51, v41
  v_perm_b32 v30, v51, v51, v42
  v_perm_b32 v31, v51, v51, v43
  v_add_f32_dpp v52, v52, v52 row_bcast:31 row_mask:0xc bank_mask:0xf
  s_waitcnt vmcnt(9)
  v_mfma_f32_16x16x32_bf16 v[44:47], v[116:119], v[24:27], v[44:47]
  v_mov_b32_dpp v48, v56 row_newbcast:8 row_mask:0xf bank_mask:0xf
  v_perm_b32 v16, v48, v48, v40
  v_perm_b32 v17, v48, v48, v41
  v_perm_b32 v18, v48, v48, v42
  v_perm_b32 v19, v48, v48, v43
  v_readlane_b32 s37, v52, 63
  s_waitcnt vmcnt(8)
  v_mfma_f32_16x16x32_bf16 v[44:47], v[120:123], v[28:31], v[44:47]
  v_mov_b32_dpp v49, v56 row_newbcast:9 row_mask:0xf bank_mask:0xf
  v_perm_b32 v20, v49, v49, v40
  v_perm_b32 v21, v49, v49, v41
  v_perm_b32 v22, v49, v49, v42
  v_perm_b32 v23, v49, v49, v43
  v_mov_b32 v4, s33
  s_waitcnt vmcnt(7)
  v_mfma_f32_16x16x32_bf16 v[44:47], v[124:127], v[16:19], v[44:47]
  v_mov_b32_dpp v50, v56 row_newbcast:10 row_mask:0xf bank_mask:0xf
  v_perm_b32 v24, v50, v50, v40
  v_perm_b32 v25, v50, v50, v41
  v_perm_b32 v26, v50, v50, v42
  v_perm_b32 v27, v50, v50, v43
  v_mov_b32 v5, s37
  s_waitcnt vmcnt(6)
  v_mfma_f32_16x16x32_bf16 v[44:47], v[128:131], v[20:23], v[44:47]
  v_mov_b32_dpp v51, v56 row_newbcast:11 row_mask:0xf bank_mask:0xf
  v_perm_b32 v28, v51, v51, v40
  v_perm_b32 v29, v51, v51, v41
  v_perm_b32 v30, v51, v51, v42
  v_perm_b32 v31, v51, v51, v43
  ds_write_b64 v55, v[4:5] offset:2048
  s_waitcnt vmcnt(5)
  v_mfma_f32_16x16x32_bf16 v[44:47], v[132:135], v[24:27], v[44:47]
  v_mov_b32_dpp v48, v56 row_newbcast:12 row_mask:0xf bank_mask:0xf
  v_perm_b32 v16, v48, v48, v40
  v_perm_b32 v17, v48, v48, v41
  v_perm_b32 v18, v48, v48, v42
  v_perm_b32 v19, v48, v48, v43
  s_waitcnt vmcnt(4)
  v_mfma_f32_16x16x32_bf16 v[44:47], v[136:139], v[28:31], v[44:47]
  v_mov_b32_dpp v49, v56 row_newbcast:13 row_mask:0xf bank_mask:0xf
  v_perm_b32 v20, v49, v49, v40
  v_perm_b32 v21, v49, v49, v41
  v_perm_b32 v22, v49, v49, v42
  v_perm_b32 v23, v49, v49, v43
  s_waitcnt vmcnt(3)
  v_mfma_f32_16x16x32_bf16 v[44:47], v[140:143], v[16:19], v[44:47]
  v_mov_b32_dpp v50, v56 row_newbcast:14 row_mask:0xf bank_mask:0xf
  v_perm_b32 v24, v50, v50, v40
  v_perm_b32 v25, v50, v50, v41
  v_perm_b32 v26, v50, v50, v42
  v_perm_b32 v27, v50, v50, v43
  s_waitcnt vmcnt(2)
  v_mfma_f32_16x16x32_bf16 v[44:47], v[144:147], v[20:23], v[44:47]
  v_mov_b32_dpp v51, v56 row_newbcast:15 row_mask:0xf bank_mask:0xf
  v_perm_b32 v28, v51, v51, v40
  v_perm_b32 v29, v51, v51, v41
  v_perm_b32 v30, v51, v51, v42
  v_perm_b32 v31, v51, v51, v43
  s_waitcnt vmcnt(1)
  v_mfma_f32_16x16x32_bf16 v[44:47], v[148:151], v[24:27], v[44:47]
  s_waitcnt vmcnt(0)
  v_mfma_f32_16x16x32_bf16 v[44:47], v[152:155], v[28:31], v[44:47]
  v_and_b32 v6, 3, v0
  v_lshlrev_b32 v6, 3, v6
  v_lshlrev_b32 v7, 3, v0
  v_lshlrev_b32 v14, 2, v0
  s_nop 3
  v_add_f32_dpp v44, v44, v44 row_ror:8 row_mask:0xf bank_mask:0xf
  v_add_f32_dpp v45, v45, v45 row_ror:8 row_mask:0xf bank_mask:0xf
  v_add_f32_dpp v46, v46, v46 row_ror:8 row_mask:0xf bank_mask:0xf
  v_add_f32_dpp v47, v47, v47 row_ror:8 row_mask:0xf bank_mask:0xf
  ds_write_b32 v54, v44 offset:0
  ds_write_b32 v54, v45 offset:32
  ds_write_b32 v54, v46 offset:64
  ds_write_b32 v54, v47 offset:96
  s_waitcnt lgkmcnt(0)
  s_barrier
  s_cmp_lg_u32 s28, 0
  s_cbranch_scc1 L_end
  ds_read_b64 v[8:9], v6 offset:2048
  ds_read_b64 v[102:103], v7 offset:0
  ds_read_b64 v[104:105], v7 offset:512
  ds_read_b64 v[106:107], v7 offset:1024
  ds_read_b64 v[108:109], v7 offset:1536
  s_waitcnt lgkmcnt(4)
  v_max_f32_dpp v10, v8, v8 row_ror:1 row_mask:0xf bank_mask:0xf
  s_nop 1
  v_max_f32_dpp v10, v10, v10 row_ror:2 row_mask:0xf bank_mask:0xf
  v_sub_f32 v11, v8, v10
  v_mul_f32 v11, s32, v11
  v_exp_f32 v11, v11
  s_nop 0
  v_mul_f32 v12, v11, v9
  s_nop 1
  v_add_f32_dpp v12, v12, v12 row_ror:1 row_mask:0xf bank_mask:0xf
  s_nop 1
  v_add_f32_dpp v12, v12, v12 row_ror:2 row_mask:0xf bank_mask:0xf
  v_rcp_f32 v12, v12
  s_waitcnt lgkmcnt(0)
  v_mul_f32_dpp v4, v11, v102 row_newbcast:0 row_mask:0xf bank_mask:0xf
  v_mul_f32_dpp v5, v11, v103 row_newbcast:0 row_mask:0xf bank_mask:0xf
  s_nop 0
  v_fmac_f32_dpp v4, v11, v104 row_newbcast:1 row_mask:0xf bank_mask:0xf
  v_fmac_f32_dpp v5, v11, v105 row_newbcast:1 row_mask:0xf bank_mask:0xf
  s_nop 0
  v_fmac_f32_dpp v4, v11, v106 row_newbcast:2 row_mask:0xf bank_mask:0xf
  v_fmac_f32_dpp v5, v11, v107 row_newbcast:2 row_mask:0xf bank_mask:0xf
  s_nop 0
  v_fmac_f32_dpp v4, v11, v108 row_newbcast:3 row_mask:0xf bank_mask:0xf
  v_fmac_f32_dpp v5, v11, v109 row_newbcast:3 row_mask:0xf bank_mask:0xf
  v_mul_f32 v4, v4, v12
  v_mul_f32 v5, v5, v12
  v_cvt_pk_bf16_f32 v4, v4, v5
  buffer_store_dword v4, v14, s[24:27], s35 offen
  s_endpgm
L_ctl:
  v_and_b32 v1, 3, v0
  v_lshlrev_b32 v1, 2, v1
  v_mov_b32 v2, 0
  v_mov_b32 v3, s39
  v_mov_b32 v11, 0
  v_mov_b32 v14, 0
  v_add_u32 v15, v14, v0
  v_xor_b32 v14, v14, v15
  v_lshrrev_b32 v14, 4, v14
  v_min_u32 v14, 1, v14
  v_lshl_or_b32 v11, v14, 0, v11
  v_mov_b32 v14, v15
  v_add_u32 v15, v14, v0
  v_xor_b32 v14, v14, v15
  v_lshrrev_b32 v14, 4, v14
  v_min_u32 v14, 1, v14
  v_lshl_or_b32 v11, v14, 1, v11
  v_mov_b32 v14, v15
  v_add_u32 v15, v14, v0
  v_xor_b32 v14, v14, v15
  v_lshrrev_b32 v14, 4, v14
  v_min_u32 v14, 1, v14
  v_lshl_or_b32 v11, v14, 2, v11
  v_mov_b32 v14, v15
  v_add_u32 v15, v14, v0
  v_xor_b32 v14, v14, v15
  v_lshrrev_b32 v14, 4, v14
  v_min_u32 v14, 1, v14
  v_lshl_or_b32 v11, v14, 3, v11
  v_mov_b32 v14, v15
  v_add_u32 v15, v14, v0
  v_xor_b32 v14, v14, v15
  v_lshrrev_b32 v14, 4, v14
  v_min_u32 v14, 1, v14
  v_lshl_or_b32 v11, v14, 4, v11
  v_mov_b32 v14, v15
  v_add_u32 v15, v14, v0
  v_xor_b32 v14, v14, v15
  v_lshrrev_b32 v14, 4, v14
  v_min_u32 v14, 1, v14
  v_lshl_or_b32 v11, v14, 5, v11
  v_mov_b32 v14, v15
  v_add_u32 v15, v14, v0
  v_xor_b32 v14, v14, v15
  v_lshrrev_b32 v14, 4, v14
  v_min_u32 v14, 1, v14
  v_lshl_or_b32 v11, v14, 6, v11
  v_mov_b32 v14, v15
  v_add_u32 v15, v14, v0
  v_xor_b32 v14, v14, v15
  v_lshrrev_b32 v14, 4, v14
  v_min_u32 v14, 1, v14
  v_lshl_or_b32 v11, v14, 7, v11
  v_mov_b32 v14, v15
  v_add_u32 v15, v14, v0
  v_xor_b32 v14, v14, v15
  v_lshrrev_b32 v14, 4, v14
  v_min_u32 v14, 1, v14
  v_lshl_or_b32 v11, v14, 8, v11
  v_mov_b32 v14, v15
  v_add_u32 v15, v14, v0
  v_xor_b32 v14, v14, v15
  v_lshrrev_b32 v14, 4, v14
  v_min_u32 v14, 1, v14
  v_lshl_or_b32 v11, v14, 9, v11
  v_mov_b32 v14, v15
  v_add_u32 v15, v14, v0
  v_xor_b32 v14, v14, v15
  v_lshrrev_b32 v14, 4, v14
  v_min_u32 v14, 1, v14
  v_lshl_or_b32 v11, v14, 10, v11
  v_mov_b32 v14, v15
  v_add_u32 v15, v14, v0
  v_xor_b32 v14, v14, v15
  v_lshrrev_b32 v14, 4, v14
  v_min_u32 v14, 1, v14
  v_lshl_or_b32 v11, v14, 11, v11
  v_mov_b32 v14, v15
  v_add_u32 v15, v14, v0
  v_xor_b32 v14, v14, v15
  v_lshrrev_b32 v14, 4, v14
  v_min_u32 v14, 1, v14
  v_lshl_or_b32 v11, v14, 12, v11
  v_mov_b32 v14, v15
  v_add_u32 v15, v14, v0
  v_xor_b32 v14, v14, v15
  v_lshrrev_b32 v14, 4, v14
  v_min_u32 v14, 1, v14
  v_lshl_or_b32 v11, v14, 13, v11
  v_mov_b32 v14, v15
  v_add_u32 v15, v14, v0
  v_xor_b32 v14, v14, v15
  v_lshrrev_b32 v14, 4, v14
  v_min_u32 v14, 1, v14
  v_lshl_or_b32 v11, v14, 14, v11
  v_mov_b32 v14, v15
  v_add_u32 v15, v14, v0
  v_xor_b32 v14, v14, v15
  v_lshrrev_b32 v14, 4, v14
  v_min_u32 v14, 1, v14
  v_lshl_or_b32 v11, v14, 15, v11
  v_mov_b32 v14, v15
  ds_write_b32 v1, v2 offset:2080
  ds_write_b32 v1, v3 offset:2096
  s_mov_b32 s58, 256
  s_mov_b32 s59, 0x00020000
  v_lshlrev_b32 v4, 2, v0
  v_mov_b32 v5, 0x80000000
  v_writelane_b32 v5, s2, 0
  s_mov_b32 s21, 0
  s_mov_b32 s22, 0x7f7f7f7f
  s_mov_b32 s23, 0x80808080
  v_cvt_f32_u32 v12, s34
  s_mov_b32 s24, 0x3fc00000
  s_mov_b32 s20, 0xbf000000
  s_waitcnt lgkmcnt(0)
  s_barrier
L_cpoll:
  ds_read_b32 v2, v1 offset:2080
  s_waitcnt lgkmcnt(0)
  s_nop 0
  v_add_u32_dpp v13, v2, v2 quad_perm:[1,0,3,2] row_mask:0xf bank_mask:0xf
  s_nop 1
  v_add_u32_dpp v13, v13, v13 quad_perm:[2,3,0,1] row_mask:0xf bank_mask:0xf
  v_lshrrev_b32 v13, 3, v13
  s_nop 0
  v_readfirstlane_b32 s25, v13
  s_nop 0
  s_cmp_le_u32 s25, s21
  s_cbranch_scc1 L_cpoll
  s_mov_b32 s21, s25
  buffer_store_byte v13, v5, s[56:59], 0 offen
  buffer_load_dword v6, v4, s[56:59], 0 offen sc1
  v_cvt_f32_u32 v10, v2
  s_waitcnt vmcnt(0)
  v_sad_u8 v7, v6, 0, 0
  v_and_b32 v8, s22, v6
  v_add_u32 v8, s22, v8
  v_or_b32 v8, v8, v6
  v_and_b32 v8, s23, v8
  v_bcnt_u32_b32 v8, v8, 0
  v_lshl_add_u32 v7, v8, 16, v7
  s_nop 1
  v_add_u32_dpp v7, v7, v7 row_ror:1 row_mask:0xf bank_mask:0xf
  s_nop 1
  v_add_u32_dpp v7, v7, v7 row_ror:2 row_mask:0xf bank_mask:0xf
  s_nop 1
  v_add_u32_dpp v7, v7, v7 row_ror:4 row_mask:0xf bank_mask:0xf
  s_nop 1
  v_add_u32_dpp v7, v7, v7 row_ror:8 row_mask:0xf bank_mask:0xf
  s_nop 1
  v_add_u32_dpp v7, v7, v7 row_bcast:15 row_mask:0xa bank_mask:0xf
  s_nop 1
  v_add_u32_dpp v7, v7, v7 row_bcast:31 row_mask:0xc bank_mask:0xf
  s_nop 0
  v_readlane_b32 s26, v7, 63
  s_nop 0
  s_and_b32 s27, s26, 0xffff
  s_lshr_b32 s26, s26, 16
  s_max_u32 s26, s26, 1
  v_cvt_f32_u32 v8, s26
  v_cvt_f32_u32 v9, s27
  v_rcp_f32 v8, v8
  v_subrev_f32 v10, s20, v10
  v_fma_f32 v9, v9, v8, 0.5
  v_mul_f32 v9, 0x40000000, v9
  v_sub_f32 v9, v9, v10
  v_fma_f32 v9, v9, s24, v12
  v_rndne_f32 v9, v9
  v_max_f32 v9, 0, v9
  v_min_f32 v9, 0x41400000, v9
  v_cvt_u32_f32 v3, v9
  v_lshlrev_b32 v3, 2, v3
  ds_bpermute_b32 v3, v3, v11
  s_waitcnt lgkmcnt(0)
  ds_write_b32 v1, v3 offset:2096
  s_cmp_lt_u32 s21, 124
  s_cbranch_scc1 L_cpoll
L_end:
  s_endpgm
.section .rodata,"a"
.p2align 6
.amdhsa_kernel standalone__mha_softmax__sampling_kernel
  .amdhsa_next_free_vgpr 160
  .amdhsa_next_free_sgpr 64
  .amdhsa_accum_offset 160
  .amdhsa_group_segment_fixed_size 0
  .amdhsa_kernarg_size 48
  .amdhsa_user_sgpr_count 2
  .amdhsa_user_sgpr_kernarg_segment_ptr 1
  .amdhsa_system_sgpr_workgroup_id_x 1
.end_amdhsa_kernel
```
